```python
import torch

def _softmax(x, axis=-1):
    return torch.softmax(x, dim=axis)
def _gelu(x):
    return torch.nn.functional.gelu(x, approximate="tanh")
def _silu(x):
    return torch.nn.functional.silu(x)
def _sigmoid(x):
    return torch.sigmoid(x)
def _layernorm(x, axis=-1, eps=1e-5):
    m = x.mean(dim=axis, keepdim=True)
    v = x.var(dim=axis, keepdim=True, unbiased=False)
    return (x - m) / torch.sqrt(v + eps)
def _scatter_add(tgt, idx, src, axis=0):
    return tgt.clone().index_add_(axis, idx, src)
def _segment_sum(src, seg, n):
    out = torch.zeros((n,) + src.shape[1:], dtype=src.dtype)
    return out.index_add_(0, seg, src)
def _pad(x, pw):
    flat = tuple(v for pair in reversed(pw) for v in pair)
    return torch.nn.functional.pad(x, flat)

kernel_name = 'standalone__gqa_softmax__near_ridge'

def setup_inputs():

    _w = (lambda a: (lambda t: t.to(torch.bfloat16) if t.is_floating_point() else t)(torch.as_tensor(a)))
    B, Hq, Hkv, Sq, Sk, D = 8, 32, 8, 384, 384, 128
    return {
        "q": _w((lambda *s: torch.randn(*s, dtype=torch.bfloat16) * 0.8)(B, Hq, Sq, D)),
        "k": _w((lambda *s: torch.randn(*s, dtype=torch.bfloat16) * 0.8)(B, Hkv, Sk, D)),
        "v": _w((lambda *s: torch.randn(*s, dtype=torch.bfloat16) * 0.05)(B, Hkv, Sk, D)),
    }

def reference(q, k, v):
    B, Hq, Sq, D = q.shape
    Hkv = k.shape[1]
    rep = Hq // Hkv
    k = (lambda x, n, axis: torch.repeat_interleave(x, n, dim=axis))(k, rep, axis=1)
    v = (lambda x, n, axis: torch.repeat_interleave(x, n, dim=axis))(v, rep, axis=1)
    scale = D ** -0.5
    scores = torch.einsum("bhqd,bhkd->bhqk", q, k) * scale
    p = _softmax(scores, axis=-1)
    return torch.einsum("bhqk,bhkd->bhqd", p, v)
```

```asm
; @launch grid=(256,1,1) block=(768,1,1) lds=163840
.amdgcn_target "amdgcn-amd-amdhsa--gfx950"
.text
.globl standalone__gqa_softmax__near_ridge_kernel
.p2align 8
.type standalone__gqa_softmax__near_ridge_kernel,@function
standalone__gqa_softmax__near_ridge_kernel:
    s_cmp_ge_u32 s2, 256
    s_cbranch_scc1 Lend
    s_load_dwordx4 s[4:7], s[0:1], 0
    s_load_dwordx4 s[8:11], s[0:1], 16
    v_lshrrev_b32 v1, 6, v0
    s_and_b32 s3, s2, 7
    s_lshr_b32 s36, s2, 3
    v_readfirstlane_b32 s28, v1
    s_lshr_b32 s37, s36, 2
    s_lshl_b32 s3, s3, 3
    s_add_u32 s3, s3, s37
    s_and_b32 s36, s36, 3
    s_lshl_b32 s37, s3, 2
    s_add_u32 s36, s36, s37
    s_mul_i32 s38, s36, 98304
    s_mul_i32 s39, s3, 98304
    v_and_b32 v8, 63, v0
    s_and_b32 s37, s28, 3
    s_lshr_b32 s46, s28, 2
    v_lshrrev_b32 v10, 4, v8
    v_lshlrev_b32 v10, 6, v10
    v_bfe_u32 v11, v8, 2, 2
    v_lshl_add_u32 v10, v11, 8, v10
    v_and_b32 v11, 3, v8
    v_lshl_add_u32 v6, v11, 4, v10
    s_lshl_b32 s32, s37, 11
    s_mul_i32 s31, s37, 2112
    s_lshl_b32 s40, s28, 13
    s_lshl_b32 s43, s37, 13
    s_cmp_eq_u32 s46, 1
    s_cbranch_scc1 LgB
    s_cmp_eq_u32 s46, 2
    s_cbranch_scc1 LgC
    s_add_u32 s43, s43, 67584
    s_cmp_eq_u32 s37, 2
    s_cselect_b32 s43, 92928, s43
    s_cmp_eq_u32 s37, 3
    s_cselect_b32 s43, 134144, s43
    s_waitcnt lgkmcnt(0)
    s_add_u32 s16, s6, s39
    s_addc_u32 s17, s7, 0
    s_mov_b32 s18, 98304
    s_mov_b32 s19, 0x20000
    s_add_u32 s31, s31, 84480
    s_mov_b32 m0, s31
    s_add_u32 s36, s31, 32
    buffer_load_dwordx4 v6, s[16:19], s32 offen  lds
    s_mov_b32 m0, s36
    s_add_u32 s36, s31, 8448
    buffer_load_dwordx4 v6, s[16:19], s32 offen offset:1024  lds
    s_add_u32 s12, s4, s38
    s_addc_u32 s13, s5, 0
    s_mov_b32 s14, 98304
    s_mov_b32 s15, 0x20000
    s_mov_b32 m0, s43
    s_add_u32 s36, s43, 4096
    buffer_load_dwordx4 v6, s[12:15], s40 offen offset:0  lds
    buffer_load_dwordx4 v6, s[12:15], s40 offen offset:1024  lds
    buffer_load_dwordx4 v6, s[12:15], s40 offen offset:2048  lds
    buffer_load_dwordx4 v6, s[12:15], s40 offen offset:3072  lds
    s_mov_b32 m0, s36
    s_add_u32 s36, s40, 4096
    buffer_load_dwordx4 v6, s[12:15], s36 offen offset:0  lds
    buffer_load_dwordx4 v6, s[12:15], s36 offen offset:1024  lds
    buffer_load_dwordx4 v6, s[12:15], s36 offen offset:2048  lds
    buffer_load_dwordx4 v6, s[12:15], s36 offen offset:3072  lds
    s_add_u32 s20, s8, s39
    s_addc_u32 s21, s9, 0
    s_mov_b32 s22, 98304
    s_mov_b32 s23, 0x20000
    s_add_u32 s24, s10, s38
    s_addc_u32 s25, s11, 0
    s_mov_b32 s26, 98304
    s_mov_b32 s27, 0x20000
    v_bfe_u32 v12, v8, 2, 2
    v_and_b32 v11, 3, v8
    v_lshrrev_b32 v13, 4, v8
    v_lshlrev_b32 v10, 6, v11
    v_lshl_add_u32 v10, v13, 4, v10
    v_lshl_add_u32 v9, v12, 10, v10
    v_add_u32 v9, s43, v9
    v_mul_u32_u24 v14, 1056, v12
    v_add_u32 v0, v14, v10
    v_mul_u32_u24 v14, 1056, v13
    v_lshl_add_u32 v14, v12, 6, v14
    v_lshl_add_u32 v1, v11, 3, v14
    v_add_u32 v0, 67584, v0
    v_mov_b32 v4, 0
    v_mov_b32 v5, 0
    v_mov_b32 v72, 0
    v_mov_b32 v73, 0
    v_mov_b32 v74, 0
    v_mov_b32 v75, 0
    v_mov_b32 v76, 0
    v_mov_b32 v77, 0
    v_mov_b32 v78, 0
    v_mov_b32 v79, 0
    v_mov_b32 v80, 0
    v_mov_b32 v81, 0
    v_mov_b32 v82, 0
    v_mov_b32 v83, 0
    v_mov_b32 v84, 0
    v_mov_b32 v85, 0
    v_mov_b32 v86, 0
    v_mov_b32 v87, 0
    v_mov_b32 v88, 0
    v_mov_b32 v89, 0
    v_mov_b32 v90, 0
    v_mov_b32 v91, 0
    v_mov_b32 v92, 0
    v_mov_b32 v93, 0
    v_mov_b32 v94, 0
    v_mov_b32 v95, 0
    v_mov_b32 v96, 0
    v_mov_b32 v97, 0
    v_mov_b32 v98, 0
    v_mov_b32 v99, 0
    v_mov_b32 v100, 0
    v_mov_b32 v101, 0
    v_mov_b32 v102, 0
    v_mov_b32 v103, 0
    v_mov_b32 v104, 0
    v_mov_b32 v105, 0
    v_mov_b32 v106, 0
    v_mov_b32 v107, 0
    v_mov_b32 v108, 0
    v_mov_b32 v109, 0
    v_mov_b32 v110, 0
    v_mov_b32 v111, 0
    v_mov_b32 v112, 0
    v_mov_b32 v113, 0
    v_mov_b32 v114, 0
    v_mov_b32 v115, 0
    v_mov_b32 v116, 0
    v_mov_b32 v117, 0
    v_mov_b32 v118, 0
    v_mov_b32 v119, 0
    v_mov_b32 v120, 0
    v_mov_b32 v121, 0
    v_mov_b32 v122, 0
    v_mov_b32 v123, 0
    v_mov_b32 v124, 0
    v_mov_b32 v125, 0
    v_mov_b32 v126, 0
    v_mov_b32 v127, 0
    v_mov_b32 v128, 0
    v_mov_b32 v129, 0
    v_mov_b32 v130, 0
    v_mov_b32 v131, 0
    v_mov_b32 v132, 0
    v_mov_b32 v133, 0
    v_mov_b32 v134, 0
    v_mov_b32 v135, 0
    s_mov_b32 s30, 0x3e0293ee
    s_mov_b32 s44, 0x46800000
    s_mov_b32 s34, 2
    s_mov_b32 s35, 5
    s_mov_b32 s41, 0
    s_mov_b32 s39, 5
    s_mov_b32 s42, 2
    s_mov_b32 s29, 0
    s_waitcnt vmcnt(8)
    s_barrier
    s_setprio 3
    ds_read_b128 v[40:43], v0 offset:16896
    ds_read_b128 v[44:47], v0 offset:17152
    ds_read_b128 v[48:51], v0 offset:17408
    ds_read_b128 v[52:55], v0 offset:17664
    ds_read_b128 v[56:59], v0 offset:21120
    ds_read_b128 v[60:63], v0 offset:21376
    ds_read_b128 v[64:67], v0 offset:21632
    ds_read_b128 v[68:71], v0 offset:21888
    v_add_u32 v0, 4294899712, v0
    s_waitcnt vmcnt(0)
    ds_read_b128 v[136:139], v9 offset:0
    ds_read_b128 v[152:155], v9 offset:4096
    ds_read_b128 v[140:143], v9 offset:256
    ds_read_b128 v[156:159], v9 offset:4352
    ds_read_b128 v[144:147], v9 offset:512
    ds_read_b128 v[160:163], v9 offset:4608
    ds_read_b128 v[148:151], v9 offset:768
    ds_read_b128 v[164:167], v9 offset:4864
    s_mov_b32 s40, 0
    s_lshl_b32 s32, s37, 11
    s_mul_i32 s31, s37, 2112
    s_add_u32 s33, s32, 65536
    s_add_u32 s32, s32, 73728
    s_add_u32 s31, s31, 33792
    s_waitcnt lgkmcnt(6)
    v_mfma_f32_16x16x32_bf16 v[8:11], v[40:43], v[136:139], 0
    v_mfma_f32_16x16x32_bf16 v[16:19], v[40:43], v[152:155], 0
    s_waitcnt lgkmcnt(4)
    v_mfma_f32_16x16x32_bf16 v[8:11], v[44:47], v[140:143], v[8:11]
    v_mfma_f32_16x16x32_bf16 v[16:19], v[44:47], v[156:159], v[16:19]
    s_waitcnt lgkmcnt(2)
    v_mfma_f32_16x16x32_bf16 v[8:11], v[48:51], v[144:147], v[8:11]
    v_mfma_f32_16x16x32_bf16 v[16:19], v[48:51], v[160:163], v[16:19]
    s_waitcnt lgkmcnt(0)
    v_mfma_f32_16x16x32_bf16 v[8:11], v[52:55], v[148:151], v[8:11]
    v_mfma_f32_16x16x32_bf16 v[16:19], v[52:55], v[164:167], v[16:19]
    v_mfma_f32_16x16x32_bf16 v[12:15], v[56:59], v[136:139], 0
    v_mfma_f32_16x16x32_bf16 v[20:23], v[56:59], v[152:155], 0
    v_mfma_f32_16x16x32_bf16 v[12:15], v[60:63], v[140:143], v[12:15]
    v_mfma_f32_16x16x32_bf16 v[20:23], v[60:63], v[156:159], v[20:23]
    v_mfma_f32_16x16x32_bf16 v[12:15], v[64:67], v[144:147], v[12:15]
    v_mfma_f32_16x16x32_bf16 v[20:23], v[64:67], v[160:163], v[20:23]
    v_mfma_f32_16x16x32_bf16 v[12:15], v[68:71], v[148:151], v[12:15]
    v_mfma_f32_16x16x32_bf16 v[20:23], v[68:71], v[164:167], v[20:23]
    s_branch Ljoin
LgB:
    s_add_u32 s43, s43, 101376
    s_waitcnt lgkmcnt(0)
    s_add_u32 s16, s6, s39
    s_addc_u32 s17, s7, 0
    s_mov_b32 s18, 98304
    s_mov_b32 s19, 0x20000
    s_add_u32 s12, s4, s38
    s_addc_u32 s13, s5, 0
    s_mov_b32 s14, 98304
    s_mov_b32 s15, 0x20000
    s_add_u32 s20, s8, s39
    s_addc_u32 s21, s9, 0
    s_mov_b32 s22, 98304
    s_mov_b32 s23, 0x20000
    s_add_u32 s24, s10, s38
    s_addc_u32 s25, s11, 0
    s_mov_b32 s26, 98304
    s_mov_b32 s27, 0x20000
    v_bfe_u32 v12, v8, 2, 2
    v_and_b32 v11, 3, v8
    v_lshrrev_b32 v13, 4, v8
    v_lshlrev_b32 v10, 6, v11
    v_lshl_add_u32 v10, v13, 4, v10
    v_lshl_add_u32 v9, v12, 10, v10
    v_add_u32 v9, s43, v9
    v_mul_u32_u24 v14, 1056, v12
    v_add_u32 v0, v14, v10
    v_mul_u32_u24 v14, 1056, v13
    v_lshl_add_u32 v14, v12, 6, v14
    v_lshl_add_u32 v1, v11, 3, v14
    v_add_u32 v1, 33792, v1
    v_mov_b32 v4, 0
    v_mov_b32 v5, 0
    v_mov_b32 v72, 0
    v_mov_b32 v73, 0
    v_mov_b32 v74, 0
    v_mov_b32 v75, 0
    v_mov_b32 v76, 0
    v_mov_b32 v77, 0
    v_mov_b32 v78, 0
    v_mov_b32 v79, 0
    v_mov_b32 v80, 0
    v_mov_b32 v81, 0
    v_mov_b32 v82, 0
    v_mov_b32 v83, 0
    v_mov_b32 v84, 0
    v_mov_b32 v85, 0
    v_mov_b32 v86, 0
    v_mov_b32 v87, 0
    v_mov_b32 v88, 0
    v_mov_b32 v89, 0
    v_mov_b32 v90, 0
    v_mov_b32 v91, 0
    v_mov_b32 v92, 0
    v_mov_b32 v93, 0
    v_mov_b32 v94, 0
    v_mov_b32 v95, 0
    v_mov_b32 v96, 0
    v_mov_b32 v97, 0
    v_mov_b32 v98, 0
    v_mov_b32 v99, 0
    v_mov_b32 v100, 0
    v_mov_b32 v101, 0
    v_mov_b32 v102, 0
    v_mov_b32 v103, 0
    v_mov_b32 v104, 0
    v_mov_b32 v105, 0
    v_mov_b32 v106, 0
    v_mov_b32 v107, 0
    v_mov_b32 v108, 0
    v_mov_b32 v109, 0
    v_mov_b32 v110, 0
    v_mov_b32 v111, 0
    v_mov_b32 v112, 0
    v_mov_b32 v113, 0
    v_mov_b32 v114, 0
    v_mov_b32 v115, 0
    v_mov_b32 v116, 0
    v_mov_b32 v117, 0
    v_mov_b32 v118, 0
    v_mov_b32 v119, 0
    v_mov_b32 v120, 0
    v_mov_b32 v121, 0
    v_mov_b32 v122, 0
    v_mov_b32 v123, 0
    v_mov_b32 v124, 0
    v_mov_b32 v125, 0
    v_mov_b32 v126, 0
    v_mov_b32 v127, 0
    v_mov_b32 v128, 0
    v_mov_b32 v129, 0
    v_mov_b32 v130, 0
    v_mov_b32 v131, 0
    v_mov_b32 v132, 0
    v_mov_b32 v133, 0
    v_mov_b32 v134, 0
    v_mov_b32 v135, 0
    s_mov_b32 s30, 0x3e0293ee
    s_mov_b32 s44, 0x46800000
    s_mov_b32 s34, 5
    s_mov_b32 s35, 6
    s_mov_b32 s41, 1
    s_mov_b32 s39, 6
    s_mov_b32 s42, 1
    s_mov_b32 s29, 1
    s_barrier
    s_barrier
    s_mov_b32 m0, s43
    s_add_u32 s36, s43, 4096
    buffer_load_dwordx4 v6, s[12:15], s40 offen offset:0  lds
    buffer_load_dwordx4 v6, s[12:15], s40 offen offset:1024  lds
    buffer_load_dwordx4 v6, s[12:15], s40 offen offset:2048  lds
    buffer_load_dwordx4 v6, s[12:15], s40 offen offset:3072  lds
    s_mov_b32 m0, s36
    s_add_u32 s36, s40, 4096
    buffer_load_dwordx4 v6, s[12:15], s36 offen offset:0  lds
    buffer_load_dwordx4 v6, s[12:15], s36 offen offset:1024  lds
    buffer_load_dwordx4 v6, s[12:15], s36 offen offset:2048  lds
    buffer_load_dwordx4 v6, s[12:15], s36 offen offset:3072  lds
    s_setprio 3
    ds_read_b128 v[40:43], v0 offset:16896
    ds_read_b128 v[44:47], v0 offset:17152
    ds_read_b128 v[48:51], v0 offset:17408
    ds_read_b128 v[52:55], v0 offset:17664
    ds_read_b128 v[56:59], v0 offset:21120
    ds_read_b128 v[60:63], v0 offset:21376
    ds_read_b128 v[64:67], v0 offset:21632
    ds_read_b128 v[68:71], v0 offset:21888
    v_add_u32 v0, 33792, v0
    s_waitcnt vmcnt(0)
    ds_read_b128 v[136:139], v9 offset:0
    ds_read_b128 v[152:155], v9 offset:4096
    ds_read_b128 v[140:143], v9 offset:256
    ds_read_b128 v[156:159], v9 offset:4352
    ds_read_b128 v[144:147], v9 offset:512
    ds_read_b128 v[160:163], v9 offset:4608
    ds_read_b128 v[148:151], v9 offset:768
    ds_read_b128 v[164:167], v9 offset:4864
    s_mov_b32 s40, 16384
    s_lshl_b32 s32, s37, 11
    s_mul_i32 s31, s37, 2112
    s_add_u32 s33, s32, 16384
    s_add_u32 s32, s32, 24576
    s_add_u32 s31, s31, 33792
    s_waitcnt lgkmcnt(6)
    v_mfma_f32_16x16x32_bf16 v[8:11], v[40:43], v[136:139], 0
    v_mfma_f32_16x16x32_bf16 v[16:19], v[40:43], v[152:155], 0
    s_waitcnt lgkmcnt(4)
    v_mfma_f32_16x16x32_bf16 v[8:11], v[44:47], v[140:143], v[8:11]
    v_mfma_f32_16x16x32_bf16 v[16:19], v[44:47], v[156:159], v[16:19]
    s_waitcnt lgkmcnt(2)
    v_mfma_f32_16x16x32_bf16 v[8:11], v[48:51], v[144:147], v[8:11]
    v_mfma_f32_16x16x32_bf16 v[16:19], v[48:51], v[160:163], v[16:19]
    s_waitcnt lgkmcnt(0)
    v_mfma_f32_16x16x32_bf16 v[8:11], v[52:55], v[148:151], v[8:11]
    v_mfma_f32_16x16x32_bf16 v[16:19], v[52:55], v[164:167], v[16:19]
    v_mfma_f32_16x16x32_bf16 v[12:15], v[56:59], v[136:139], 0
    v_mfma_f32_16x16x32_bf16 v[20:23], v[56:59], v[152:155], 0
    v_mfma_f32_16x16x32_bf16 v[12:15], v[60:63], v[140:143], v[12:15]
    v_mfma_f32_16x16x32_bf16 v[20:23], v[60:63], v[156:159], v[20:23]
    v_mfma_f32_16x16x32_bf16 v[12:15], v[64:67], v[144:147], v[12:15]
    v_mfma_f32_16x16x32_bf16 v[20:23], v[64:67], v[160:163], v[20:23]
    v_mfma_f32_16x16x32_bf16 v[12:15], v[68:71], v[148:151], v[12:15]
    v_mfma_f32_16x16x32_bf16 v[20:23], v[68:71], v[164:167], v[20:23]
    s_branch Ljoin
LgC:
    s_add_u32 s43, s43, 101376
    s_waitcnt lgkmcnt(0)
    s_add_u32 s16, s6, s39
    s_addc_u32 s17, s7, 0
    s_mov_b32 s18, 98304
    s_mov_b32 s19, 0x20000
    s_add_u32 s20, s8, s39
    s_addc_u32 s21, s9, 0
    s_mov_b32 s22, 98304
    s_mov_b32 s23, 0x20000
    s_mov_b32 s33, s32
    s_add_u32 s32, s32, 8192
    s_mov_b32 m0, s31
    s_add_u32 s36, s31, 32
    buffer_load_dwordx4 v6, s[16:19], s32 offen  lds
    s_mov_b32 m0, s36
    s_add_u32 s36, s31, 8448
    buffer_load_dwordx4 v6, s[16:19], s32 offen offset:1024  lds
    s_mov_b32 m0, s36
    s_add_u32 s36, s31, 8480
    buffer_load_dwordx4 v6, s[20:23], s33 offen  lds
    s_mov_b32 m0, s36
    s_add_u32 s31, s31, 16896
    buffer_load_dwordx4 v6, s[20:23], s33 offen offset:1024  lds
    s_add_u32 s32, s32, 8192
    s_cmp_ge_u32 s32, 98304
    s_cselect_b32 s36, 98304, 0
    s_sub_u32 s32, s32, s36
    s_add_u32 s33, s33, 8192
    s_mov_b32 m0, s31
    s_add_u32 s36, s31, 32
    buffer_load_dwordx4 v6, s[16:19], s32 offen  lds
    s_mov_b32 m0, s36
    s_add_u32 s36, s31, 8448
    buffer_load_dwordx4 v6, s[16:19], s32 offen offset:1024  lds
    s_mov_b32 m0, s36
    s_add_u32 s36, s31, 8480
    buffer_load_dwordx4 v6, s[20:23], s33 offen  lds
    s_mov_b32 m0, s36
    s_add_u32 s31, s31, 16896
    buffer_load_dwordx4 v6, s[20:23], s33 offen offset:1024  lds
    s_add_u32 s32, s32, 8192
    s_cmp_ge_u32 s32, 98304
    s_cselect_b32 s36, 98304, 0
    s_sub_u32 s32, s32, s36
    s_add_u32 s33, s33, 8192
    s_cmp_ge_u32 s33, 98304
    s_cselect_b32 s36, 98304, 0
    s_sub_u32 s33, s33, s36
    s_cmp_ge_u32 s31, 101376
    s_cselect_b32 s36, 101376, 0
    s_sub_u32 s31, s31, s36
    s_add_u32 s12, s4, s38
    s_addc_u32 s13, s5, 0
    s_mov_b32 s14, 98304
    s_mov_b32 s15, 0x20000
    s_add_u32 s24, s10, s38
    s_addc_u32 s25, s11, 0
    s_mov_b32 s26, 98304
    s_mov_b32 s27, 0x20000
    v_bfe_u32 v12, v8, 2, 2
    v_and_b32 v11, 3, v8
    v_lshrrev_b32 v13, 4, v8
    v_lshlrev_b32 v10, 6, v11
    v_lshl_add_u32 v10, v13, 4, v10
    v_lshl_add_u32 v9, v12, 10, v10
    v_add_u32 v9, s43, v9
    v_mul_u32_u24 v14, 1056, v12
    v_add_u32 v0, v14, v10
    v_mul_u32_u24 v14, 1056, v13
    v_lshl_add_u32 v14, v12, 6, v14
    v_lshl_add_u32 v1, v11, 3, v14
    v_add_u32 v0, 67584, v0
    v_mov_b32 v4, 0
    v_mov_b32 v5, 0
    v_mov_b32 v72, 0
    v_mov_b32 v73, 0
    v_mov_b32 v74, 0
    v_mov_b32 v75, 0
    v_mov_b32 v76, 0
    v_mov_b32 v77, 0
    v_mov_b32 v78, 0
    v_mov_b32 v79, 0
    v_mov_b32 v80, 0
    v_mov_b32 v81, 0
    v_mov_b32 v82, 0
    v_mov_b32 v83, 0
    v_mov_b32 v84, 0
    v_mov_b32 v85, 0
    v_mov_b32 v86, 0
    v_mov_b32 v87, 0
    v_mov_b32 v88, 0
    v_mov_b32 v89, 0
    v_mov_b32 v90, 0
    v_mov_b32 v91, 0
    v_mov_b32 v92, 0
    v_mov_b32 v93, 0
    v_mov_b32 v94, 0
    v_mov_b32 v95, 0
    v_mov_b32 v96, 0
    v_mov_b32 v97, 0
    v_mov_b32 v98, 0
    v_mov_b32 v99, 0
    v_mov_b32 v100, 0
    v_mov_b32 v101, 0
    v_mov_b32 v102, 0
    v_mov_b32 v103, 0
    v_mov_b32 v104, 0
    v_mov_b32 v105, 0
    v_mov_b32 v106, 0
    v_mov_b32 v107, 0
    v_mov_b32 v108, 0
    v_mov_b32 v109, 0
    v_mov_b32 v110, 0
    v_mov_b32 v111, 0
    v_mov_b32 v112, 0
    v_mov_b32 v113, 0
    v_mov_b32 v114, 0
    v_mov_b32 v115, 0
    v_mov_b32 v116, 0
    v_mov_b32 v117, 0
    v_mov_b32 v118, 0
    v_mov_b32 v119, 0
    v_mov_b32 v120, 0
    v_mov_b32 v121, 0
    v_mov_b32 v122, 0
    v_mov_b32 v123, 0
    v_mov_b32 v124, 0
    v_mov_b32 v125, 0
    v_mov_b32 v126, 0
    v_mov_b32 v127, 0
    v_mov_b32 v128, 0
    v_mov_b32 v129, 0
    v_mov_b32 v130, 0
    v_mov_b32 v131, 0
    v_mov_b32 v132, 0
    v_mov_b32 v133, 0
    v_mov_b32 v134, 0
    v_mov_b32 v135, 0
    s_mov_b32 s30, 0x3e0293ee
    s_mov_b32 s44, 0x46800000
    s_mov_b32 s34, 6
    s_mov_b32 s35, 7
    s_mov_b32 s41, 0
    s_mov_b32 s39, 8
    s_mov_b32 s42, 0
    s_mov_b32 s29, 3
    s_barrier
    s_mov_b32 m0, s31
    s_add_u32 s36, s31, 32
    buffer_load_dwordx4 v6, s[16:19], s32 offen  lds
    s_mov_b32 m0, s36
    s_add_u32 s36, s31, 8448
    buffer_load_dwordx4 v6, s[16:19], s32 offen offset:1024  lds
    s_mov_b32 m0, s36
    s_add_u32 s36, s31, 8480
    buffer_load_dwordx4 v6, s[20:23], s33 offen  lds
    s_mov_b32 m0, s36
    s_add_u32 s31, s31, 16896
    buffer_load_dwordx4 v6, s[20:23], s33 offen offset:1024  lds
    s_add_u32 s32, s32, 8192
    s_cmp_ge_u32 s32, 98304
    s_cselect_b32 s36, 98304, 0
    s_sub_u32 s32, s32, s36
    s_add_u32 s33, s33, 8192
    s_mov_b32 m0, s31
    s_add_u32 s36, s31, 32
    buffer_load_dwordx4 v6, s[16:19], s32 offen  lds
    s_mov_b32 m0, s36
    s_add_u32 s36, s31, 8448
    buffer_load_dwordx4 v6, s[16:19], s32 offen offset:1024  lds
    s_mov_b32 m0, s36
    s_add_u32 s36, s31, 8480
    buffer_load_dwordx4 v6, s[20:23], s33 offen  lds
    s_mov_b32 m0, s36
    s_add_u32 s31, s31, 16896
    buffer_load_dwordx4 v6, s[20:23], s33 offen offset:1024  lds
    s_add_u32 s32, s32, 8192
    s_cmp_ge_u32 s32, 98304
    s_cselect_b32 s36, 98304, 0
    s_sub_u32 s32, s32, s36
    s_add_u32 s33, s33, 8192
    s_cmp_ge_u32 s33, 98304
    s_cselect_b32 s36, 98304, 0
    s_sub_u32 s33, s33, s36
    s_cmp_ge_u32 s31, 101376
    s_cselect_b32 s36, 101376, 0
    s_sub_u32 s31, s31, s36
    s_waitcnt vmcnt(8)
    s_barrier
    s_mov_b32 m0, s31
    s_add_u32 s36, s31, 32
    buffer_load_dwordx4 v6, s[16:19], s32 offen  lds
    s_mov_b32 m0, s36
    s_add_u32 s36, s31, 8448
    buffer_load_dwordx4 v6, s[16:19], s32 offen offset:1024  lds
    s_mov_b32 m0, s36
    s_add_u32 s36, s31, 8480
    buffer_load_dwordx4 v6, s[20:23], s33 offen  lds
    s_mov_b32 m0, s36
    s_add_u32 s31, s31, 16896
    buffer_load_dwordx4 v6, s[20:23], s33 offen offset:1024  lds
    s_add_u32 s32, s32, 8192
    s_cmp_ge_u32 s32, 98304
    s_cselect_b32 s36, 98304, 0
    s_sub_u32 s32, s32, s36
    s_add_u32 s33, s33, 8192
    s_mov_b32 m0, s31
    s_add_u32 s36, s31, 32
    buffer_load_dwordx4 v6, s[16:19], s32 offen  lds
    s_mov_b32 m0, s36
    s_add_u32 s36, s31, 8448
    buffer_load_dwordx4 v6, s[16:19], s32 offen offset:1024  lds
    s_mov_b32 m0, s36
    s_add_u32 s36, s31, 8480
    buffer_load_dwordx4 v6, s[20:23], s33 offen  lds
    s_mov_b32 m0, s36
    s_add_u32 s31, s31, 16896
    buffer_load_dwordx4 v6, s[20:23], s33 offen offset:1024  lds
    s_add_u32 s32, s32, 8192
    s_cmp_ge_u32 s32, 98304
    s_cselect_b32 s36, 98304, 0
    s_sub_u32 s32, s32, s36
    s_add_u32 s33, s33, 8192
    s_cmp_ge_u32 s33, 98304
    s_cselect_b32 s36, 98304, 0
    s_sub_u32 s33, s33, s36
    s_cmp_ge_u32 s31, 101376
    s_cselect_b32 s36, 101376, 0
    s_sub_u32 s31, s31, s36
    s_waitcnt vmcnt(8)
    s_barrier
    s_mov_b32 m0, s31
    s_add_u32 s36, s31, 32
    buffer_load_dwordx4 v6, s[16:19], s32 offen  lds
    s_mov_b32 m0, s36
    s_add_u32 s36, s31, 8448
    buffer_load_dwordx4 v6, s[16:19], s32 offen offset:1024  lds
    s_mov_b32 m0, s36
    s_add_u32 s36, s31, 8480
    buffer_load_dwordx4 v6, s[20:23], s33 offen  lds
    s_mov_b32 m0, s36
    s_add_u32 s31, s31, 16896
    buffer_load_dwordx4 v6, s[20:23], s33 offen offset:1024  lds
    s_add_u32 s32, s32, 8192
    s_cmp_ge_u32 s32, 98304
    s_cselect_b32 s36, 98304, 0
    s_sub_u32 s32, s32, s36
    s_add_u32 s33, s33, 8192
    s_mov_b32 m0, s31
    s_add_u32 s36, s31, 32
    buffer_load_dwordx4 v6, s[16:19], s32 offen  lds
    s_mov_b32 m0, s36
    s_add_u32 s36, s31, 8448
    buffer_load_dwordx4 v6, s[16:19], s32 offen offset:1024  lds
    s_mov_b32 m0, s36
    s_add_u32 s36, s31, 8480
    buffer_load_dwordx4 v6, s[20:23], s33 offen  lds
    s_mov_b32 m0, s36
    s_add_u32 s31, s31, 16896
    buffer_load_dwordx4 v6, s[20:23], s33 offen offset:1024  lds
    s_add_u32 s32, s32, 8192
    s_cmp_ge_u32 s32, 98304
    s_cselect_b32 s36, 98304, 0
    s_sub_u32 s32, s32, s36
    s_add_u32 s33, s33, 8192
    s_cmp_ge_u32 s33, 98304
    s_cselect_b32 s36, 98304, 0
    s_sub_u32 s33, s33, s36
    s_cmp_ge_u32 s31, 101376
    s_cselect_b32 s36, 101376, 0
    s_sub_u32 s31, s31, s36
    s_waitcnt vmcnt(8)
    s_barrier
    s_mov_b32 m0, s43
    s_add_u32 s36, s43, 4096
    buffer_load_dwordx4 v6, s[12:15], s40 offen offset:0  lds
    buffer_load_dwordx4 v6, s[12:15], s40 offen offset:1024  lds
    buffer_load_dwordx4 v6, s[12:15], s40 offen offset:2048  lds
    buffer_load_dwordx4 v6, s[12:15], s40 offen offset:3072  lds
    s_mov_b32 m0, s36
    s_add_u32 s36, s40, 4096
    buffer_load_dwordx4 v6, s[12:15], s36 offen offset:0  lds
    buffer_load_dwordx4 v6, s[12:15], s36 offen offset:1024  lds
    buffer_load_dwordx4 v6, s[12:15], s36 offen offset:2048  lds
    buffer_load_dwordx4 v6, s[12:15], s36 offen offset:3072  lds
    s_setprio 3
    ds_read_b128 v[40:43], v0 offset:16896
    ds_read_b128 v[44:47], v0 offset:17152
    ds_read_b128 v[48:51], v0 offset:17408
    ds_read_b128 v[52:55], v0 offset:17664
    ds_read_b128 v[56:59], v0 offset:21120
    ds_read_b128 v[60:63], v0 offset:21376
    ds_read_b128 v[64:67], v0 offset:21632
    ds_read_b128 v[68:71], v0 offset:21888
    v_add_u32 v0, 4294899712, v0
    s_waitcnt vmcnt(0)
    ds_read_b128 v[136:139], v9 offset:0
    ds_read_b128 v[152:155], v9 offset:4096
    ds_read_b128 v[140:143], v9 offset:256
    ds_read_b128 v[156:159], v9 offset:4352
    ds_read_b128 v[144:147], v9 offset:512
    ds_read_b128 v[160:163], v9 offset:4608
    ds_read_b128 v[148:151], v9 offset:768
    ds_read_b128 v[164:167], v9 offset:4864
    s_mov_b32 s40, 49152
    s_lshl_b32 s32, s37, 11
    s_mul_i32 s31, s37, 2112
    s_add_u32 s33, s32, 32768
    s_add_u32 s32, s32, 40960
    s_add_u32 s31, s31, 67584
    s_waitcnt lgkmcnt(6)
    v_mfma_f32_16x16x32_bf16 v[8:11], v[40:43], v[136:139], 0
    v_mfma_f32_16x16x32_bf16 v[16:19], v[40:43], v[152:155], 0
    s_waitcnt lgkmcnt(4)
    v_mfma_f32_16x16x32_bf16 v[8:11], v[44:47], v[140:143], v[8:11]
    v_mfma_f32_16x16x32_bf16 v[16:19], v[44:47], v[156:159], v[16:19]
    s_waitcnt lgkmcnt(2)
    v_mfma_f32_16x16x32_bf16 v[8:11], v[48:51], v[144:147], v[8:11]
    v_mfma_f32_16x16x32_bf16 v[16:19], v[48:51], v[160:163], v[16:19]
    s_waitcnt lgkmcnt(0)
    v_mfma_f32_16x16x32_bf16 v[8:11], v[52:55], v[148:151], v[8:11]
    v_mfma_f32_16x16x32_bf16 v[16:19], v[52:55], v[164:167], v[16:19]
    v_mfma_f32_16x16x32_bf16 v[12:15], v[56:59], v[136:139], 0
    v_mfma_f32_16x16x32_bf16 v[20:23], v[56:59], v[152:155], 0
    v_mfma_f32_16x16x32_bf16 v[12:15], v[60:63], v[140:143], v[12:15]
    v_mfma_f32_16x16x32_bf16 v[20:23], v[60:63], v[156:159], v[20:23]
    v_mfma_f32_16x16x32_bf16 v[12:15], v[64:67], v[144:147], v[12:15]
    v_mfma_f32_16x16x32_bf16 v[20:23], v[64:67], v[160:163], v[20:23]
    v_mfma_f32_16x16x32_bf16 v[12:15], v[68:71], v[148:151], v[12:15]
    v_mfma_f32_16x16x32_bf16 v[20:23], v[68:71], v[164:167], v[20:23]
Ljoin:
    s_barrier
    s_setprio 3
    ds_read_b128 v[40:43], v0 offset:0
    ds_read_b128 v[44:47], v0 offset:256
    ds_read_b128 v[48:51], v0 offset:512
    ds_read_b128 v[52:55], v0 offset:768
    ds_read_b128 v[56:59], v0 offset:4224
    ds_read_b128 v[60:63], v0 offset:4480
    ds_read_b128 v[64:67], v0 offset:4736
    ds_read_b128 v[68:71], v0 offset:4992
    s_mov_b32 s38, 0
    s_cmp_lt_u32 s29, s34
    s_cbranch_scc1 Lnl1
    s_cmp_ge_u32 s29, s35
    s_cbranch_scc1 Lnl1
    s_mov_b32 m0, s31
    s_add_u32 s36, s31, 32
    buffer_load_dwordx4 v6, s[16:19], s32 offen  lds
    s_mov_b32 m0, s36
    s_add_u32 s36, s31, 8448
    buffer_load_dwordx4 v6, s[16:19], s32 offen offset:1024  lds
    s_mov_b32 m0, s36
    s_add_u32 s36, s31, 8480
    buffer_load_dwordx4 v6, s[20:23], s33 offen  lds
    s_mov_b32 m0, s36
    s_add_u32 s31, s31, 16896
    buffer_load_dwordx4 v6, s[20:23], s33 offen offset:1024  lds
    s_add_u32 s32, s32, 8192
    s_cmp_ge_u32 s32, 98304
    s_cselect_b32 s36, 98304, 0
    s_sub_u32 s32, s32, s36
    s_add_u32 s33, s33, 8192
    s_mov_b32 m0, s31
    s_add_u32 s36, s31, 32
    buffer_load_dwordx4 v6, s[16:19], s32 offen  lds
    s_mov_b32 m0, s36
    s_add_u32 s36, s31, 8448
    buffer_load_dwordx4 v6, s[16:19], s32 offen offset:1024  lds
    s_mov_b32 m0, s36
    s_add_u32 s36, s31, 8480
    buffer_load_dwordx4 v6, s[20:23], s33 offen  lds
    s_mov_b32 m0, s36
    s_add_u32 s31, s31, 16896
    buffer_load_dwordx4 v6, s[20:23], s33 offen offset:1024  lds
    s_add_u32 s32, s32, 8192
    s_cmp_ge_u32 s32, 98304
    s_cselect_b32 s36, 98304, 0
    s_sub_u32 s32, s32, s36
    s_add_u32 s33, s33, 8192
    s_cmp_ge_u32 s33, 98304
    s_cselect_b32 s36, 98304, 0
    s_sub_u32 s33, s33, s36
    s_cmp_ge_u32 s31, 101376
    s_cselect_b32 s36, 101376, 0
    s_sub_u32 s31, s31, s36
    s_cmp_lg_u32 s29, 6
    s_cselect_b32 s38, 1, 0
Lnl1:
    s_nop 3
    v_max3_f32 v24, v8, v9, v10
    v_max3_f32 v25, v16, v17, v18
    v_max3_f32 v24, v24, v11, v12
    v_max3_f32 v25, v25, v19, v20
    v_max3_f32 v24, v24, v13, v14
    v_max3_f32 v25, v25, v21, v22
    v_max_f32 v24, v24, v15
    v_max_f32 v25, v25, v23
    s_nop 1
    v_permlane32_swap_b32 v24, v25
    v_max_f32 v24, v24, v25
    v_mov_b32 v25, v24
    s_nop 1
    v_permlane16_swap_b32 v24, v25
    v_max_f32 v24, v24, v25
    v_mul_f32 v2, s30, v24
    v_mul_f32 v3, s30, v24
    s_nop 1
    v_permlane32_swap_b32 v2, v3
    v_fma_f32 v8, v8, s30, -v2
    v_fma_f32 v9, v9, s30, -v2
    v_fma_f32 v10, v10, s30, -v2
    v_exp_f32 v8, v8
    v_fma_f32 v11, v11, s30, -v2
    v_exp_f32 v9, v9
    v_fma_f32 v12, v12, s30, -v2
    v_exp_f32 v10, v10
    v_fma_f32 v13, v13, s30, -v2
    v_exp_f32 v11, v11
    v_add_f32 v7, v8, v9
    v_cvt_pk_bf16_f32 v8, v8, v9
    v_fma_f32 v14, v14, s30, -v2
    v_exp_f32 v12, v12
    v_add_f32 v7, v7, v10
    v_fma_f32 v15, v15, s30, -v2
    v_exp_f32 v13, v13
    v_add_f32 v7, v7, v11
    v_cvt_pk_bf16_f32 v9, v10, v11
    v_fma_f32 v16, v16, s30, -v3
    v_exp_f32 v14, v14
    v_add_f32 v7, v7, v12
    v_fma_f32 v17, v17, s30, -v3
    v_exp_f32 v15, v15
    v_cvt_pk_bf16_f32 v10, v12, v13
    v_add_f32 v12, v7, v13
    v_fma_f32 v18, v18, s30, -v3
    v_exp_f32 v16, v16
    v_add_f32 v12, v12, v14
Lloop:
    s_setprio 2
    s_waitcnt lgkmcnt(4)
    v_mfma_f32_16x16x32_bf16 v[24:27], v[40:43], v[136:139], 0
    v_fma_f32 v19, v19, s30, -v3
    v_exp_f32 v17, v17
    v_mfma_f32_16x16x32_bf16 v[32:35], v[40:43], v[152:155], 0
    ds_read_b64_tr_b16 v[40:41], v1 offset:8448
    v_add_f32 v12, v12, v15
    v_cvt_pk_bf16_f32 v11, v14, v15
    v_mfma_f32_16x16x32_bf16 v[24:27], v[44:47], v[140:143], v[24:27]
    ds_read_b64_tr_b16 v[42:43], v1 offset:12672
    v_fma_f32 v20, v20, s30, -v3
    v_exp_f32 v18, v18
    v_mfma_f32_16x16x32_bf16 v[32:35], v[44:47], v[156:159], v[32:35]
    ds_read_b64_tr_b16 v[44:45], v1 offset:8480
    v_fma_f32 v21, v21, s30, -v3
    v_mfma_f32_16x16x32_bf16 v[24:27], v[48:51], v[144:147], v[24:27]
    ds_read_b64_tr_b16 v[46:47], v1 offset:12704
    v_exp_f32 v19, v19
    v_add_f32 v7, v16, v17
    v_mfma_f32_16x16x32_bf16 v[32:35], v[48:51], v[160:163], v[32:35]
    ds_read_b64_tr_b16 v[48:49], v1 offset:8704
    v_cvt_pk_bf16_f32 v16, v16, v17
    v_cmp_nge_f32 s[100:101], s44, v12
    v_mfma_f32_16x16x32_bf16 v[24:27], v[52:55], v[148:151], v[24:27]
    ds_read_b64_tr_b16 v[50:51], v1 offset:12928
    v_fma_f32 v22, v22, s30, -v3
    v_exp_f32 v20, v20
    v_mfma_f32_16x16x32_bf16 v[32:35], v[52:55], v[164:167], v[32:35]
    ds_read_b64_tr_b16 v[52:53], v1 offset:8736
    v_add_f32 v7, v7, v18
    s_waitcnt lgkmcnt(7)
    v_mfma_f32_16x16x32_bf16 v[28:31], v[56:59], v[136:139], 0
    ds_read_b64_tr_b16 v[54:55], v1 offset:12960
    v_fma_f32 v23, v23, s30, -v3
    v_exp_f32 v21, v21
    v_mfma_f32_16x16x32_bf16 v[36:39], v[56:59], v[152:155], 0
    ds_read_b64_tr_b16 v[56:57], v1 offset:8960
    v_add_f32 v7, v7, v19
    v_cvt_pk_bf16_f32 v17, v18, v19
    v_mfma_f32_16x16x32_bf16 v[28:31], v[60:63], v[140:143], v[28:31]
    ds_read_b64_tr_b16 v[58:59], v1 offset:13184
    v_exp_f32 v22, v22
    v_mfma_f32_16x16x32_bf16 v[36:39], v[60:63], v[156:159], v[36:39]
    ds_read_b64_tr_b16 v[60:61], v1 offset:8992
    v_add_f32 v7, v7, v20
    v_exp_f32 v23, v23
    v_mfma_f32_16x16x32_bf16 v[28:31], v[64:67], v[144:147], v[28:31]
    ds_read_b64_tr_b16 v[62:63], v1 offset:13216
    v_cvt_pk_bf16_f32 v18, v20, v21
    v_add_f32 v20, v7, v21
    v_mfma_f32_16x16x32_bf16 v[36:39], v[64:67], v[160:163], v[36:39]
    ds_read_b64_tr_b16 v[64:65], v1 offset:9216
    v_add_f32 v20, v20, v22
    v_add_f32 v20, v20, v23
    v_mfma_f32_16x16x32_bf16 v[28:31], v[68:71], v[148:151], v[28:31]
    ds_read_b64_tr_b16 v[66:67], v1 offset:13440
    v_cvt_pk_bf16_f32 v19, v22, v23
    v_cmp_nge_f32 vcc, s44, v20
    v_mfma_f32_16x16x32_bf16 v[36:39], v[68:71], v[164:167], v[36:39]
    ds_read_b64_tr_b16 v[68:69], v1 offset:9248
    ds_read_b64_tr_b16 v[70:71], v1 offset:13472
    s_or_b64 vcc, vcc, s[100:101]
    s_cbranch_scc1 Lfb0
Lret0:
    s_setprio 2
    s_waitcnt lgkmcnt(8)
    v_mfma_f32_16x16x32_bf16 v[72:75], v[40:43], v[8:11], v[72:75]
    v_add_f32 v4, v4, v12
    v_add_f32 v5, v5, v20
    v_fma_f32 v24, v24, s30, -v2
    v_fma_f32 v25, v25, s30, -v2
    v_fma_f32 v26, v26, s30, -v2
    v_mfma_f32_16x16x32_bf16 v[76:79], v[40:43], v[16:19], v[76:79]
    ds_read_b128 v[40:43], v0 offset:16896
    v_exp_f32 v24, v24
    v_mfma_f32_16x16x32_bf16 v[80:83], v[44:47], v[8:11], v[80:83]
    v_fma_f32 v27, v27, s30, -v2
    v_exp_f32 v25, v25
    v_mfma_f32_16x16x32_bf16 v[84:87], v[44:47], v[16:19], v[84:87]
    ds_read_b128 v[44:47], v0 offset:17152
    v_fma_f32 v28, v28, s30, -v2
    v_mfma_f32_16x16x32_bf16 v[88:91], v[48:51], v[8:11], v[88:91]
    v_exp_f32 v26, v26
    v_fma_f32 v29, v29, s30, -v2
    v_mfma_f32_16x16x32_bf16 v[92:95], v[48:51], v[16:19], v[92:95]
    ds_read_b128 v[48:51], v0 offset:17408
    v_exp_f32 v27, v27
    v_mfma_f32_16x16x32_bf16 v[96:99], v[52:55], v[8:11], v[96:99]
    v_add_f32 v7, v24, v25
    v_cvt_pk_bf16_f32 v24, v24, v25
    v_fma_f32 v30, v30, s30, -v2
    v_mfma_f32_16x16x32_bf16 v[100:103], v[52:55], v[16:19], v[100:103]
    ds_read_b128 v[52:55], v0 offset:17664
    v_exp_f32 v28, v28
    s_waitcnt lgkmcnt(4)
    v_mfma_f32_16x16x32_bf16 v[104:107], v[56:59], v[8:11], v[104:107]
    v_add_f32 v7, v7, v26
    v_fma_f32 v31, v31, s30, -v2
    v_mfma_f32_16x16x32_bf16 v[108:111], v[56:59], v[16:19], v[108:111]
    ds_read_b128 v[56:59], v0 offset:21120
    v_exp_f32 v29, v29
    v_add_f32 v7, v7, v27
    v_mfma_f32_16x16x32_bf16 v[112:115], v[60:63], v[8:11], v[112:115]
    v_cvt_pk_bf16_f32 v25, v26, v27
    v_fma_f32 v32, v32, s30, -v3
    v_mfma_f32_16x16x32_bf16 v[116:119], v[60:63], v[16:19], v[116:119]
    ds_read_b128 v[60:63], v0 offset:21376
    v_exp_f32 v30, v30
    v_add_f32 v7, v7, v28
    v_mfma_f32_16x16x32_bf16 v[120:123], v[64:67], v[8:11], v[120:123]
    v_fma_f32 v33, v33, s30, -v3
    v_exp_f32 v31, v31
    v_mfma_f32_16x16x32_bf16 v[124:127], v[64:67], v[16:19], v[124:127]
    ds_read_b128 v[64:67], v0 offset:21632
    v_cvt_pk_bf16_f32 v26, v28, v29
    v_mfma_f32_16x16x32_bf16 v[128:131], v[68:71], v[8:11], v[128:131]
    v_add_f32 v28, v7, v29
    v_fma_f32 v34, v34, s30, -v3
    v_mfma_f32_16x16x32_bf16 v[132:135], v[68:71], v[16:19], v[132:135]
    ds_read_b128 v[68:71], v0 offset:21888
    v_exp_f32 v32, v32
    v_add_f32 v28, v28, v30
    s_cmp_eq_u32 s29, s39
    s_cbranch_scc1 Ltail
    s_setprio 1
    s_waitcnt lgkmcnt(4)
    v_mfma_f32_16x16x32_bf16 v[8:11], v[40:43], v[136:139], 0
    s_add_u32 s41, s41, 1
    s_cmp_eq_u32 s41, 3
    s_cselect_b32 s41, 0, s41
    s_cselect_b32 s47, 101376, 0
    s_sub_u32 s47, 33792, s47
    v_add_u32 v0, s47, v0
    v_fma_f32 v35, v35, s30, -v3
    v_exp_f32 v33, v33
    v_mfma_f32_16x16x32_bf16 v[16:19], v[40:43], v[152:155], 0
    ds_read_b64_tr_b16 v[40:41], v1 offset:25344
    v_add_f32 v28, v28, v31
    v_cvt_pk_bf16_f32 v27, v30, v31
    v_mfma_f32_16x16x32_bf16 v[8:11], v[44:47], v[140:143], v[8:11]
    ds_read_b64_tr_b16 v[42:43], v1 offset:29568
    v_fma_f32 v36, v36, s30, -v3
    v_exp_f32 v34, v34
    v_mfma_f32_16x16x32_bf16 v[16:19], v[44:47], v[156:159], v[16:19]
    ds_read_b64_tr_b16 v[44:45], v1 offset:25376
    v_fma_f32 v37, v37, s30, -v3
    v_mfma_f32_16x16x32_bf16 v[8:11], v[48:51], v[144:147], v[8:11]
    ds_read_b64_tr_b16 v[46:47], v1 offset:29600
    v_exp_f32 v35, v35
    v_add_f32 v7, v32, v33
    v_mfma_f32_16x16x32_bf16 v[16:19], v[48:51], v[160:163], v[16:19]
    ds_read_b64_tr_b16 v[48:49], v1 offset:25600
    v_cvt_pk_bf16_f32 v32, v32, v33
    v_cmp_nge_f32 s[100:101], s44, v28
    v_mfma_f32_16x16x32_bf16 v[8:11], v[52:55], v[148:151], v[8:11]
    ds_read_b64_tr_b16 v[50:51], v1 offset:29824
    v_fma_f32 v38, v38, s30, -v3
    v_exp_f32 v36, v36
    v_mfma_f32_16x16x32_bf16 v[16:19], v[52:55], v[164:167], v[16:19]
    ds_read_b64_tr_b16 v[52:53], v1 offset:25632
    v_add_f32 v7, v7, v34
    s_waitcnt lgkmcnt(7)
    v_mfma_f32_16x16x32_bf16 v[12:15], v[56:59], v[136:139], 0
    ds_read_b64_tr_b16 v[54:55], v1 offset:29856
    v_fma_f32 v39, v39, s30, -v3
    v_exp_f32 v37, v37
    v_mfma_f32_16x16x32_bf16 v[20:23], v[56:59], v[152:155], 0
    ds_read_b64_tr_b16 v[56:57], v1 offset:25856
    v_add_f32 v7, v7, v35
    v_cvt_pk_bf16_f32 v33, v34, v35
    v_mfma_f32_16x16x32_bf16 v[12:15], v[60:63], v[140:143], v[12:15]
    ds_read_b64_tr_b16 v[58:59], v1 offset:30080
    v_exp_f32 v38, v38
    v_mfma_f32_16x16x32_bf16 v[20:23], v[60:63], v[156:159], v[20:23]
    ds_read_b64_tr_b16 v[60:61], v1 offset:25888
    v_add_f32 v7, v7, v36
    v_exp_f32 v39, v39
    v_mfma_f32_16x16x32_bf16 v[12:15], v[64:67], v[144:147], v[12:15]
    ds_read_b64_tr_b16 v[62:63], v1 offset:30112
    v_cvt_pk_bf16_f32 v34, v36, v37
    v_add_f32 v36, v7, v37
    v_mfma_f32_16x16x32_bf16 v[20:23], v[64:67], v[160:163], v[20:23]
    ds_read_b64_tr_b16 v[64:65], v1 offset:26112
    v_add_f32 v36, v36, v38
    v_add_f32 v36, v36, v39
    v_mfma_f32_16x16x32_bf16 v[12:15], v[68:71], v[148:151], v[12:15]
    ds_read_b64_tr_b16 v[66:67], v1 offset:30336
    v_cvt_pk_bf16_f32 v35, v38, v39
    v_cmp_nge_f32 vcc, s44, v36
    v_mfma_f32_16x16x32_bf16 v[20:23], v[68:71], v[164:167], v[20:23]
    ds_read_b64_tr_b16 v[68:69], v1 offset:26144
    ds_read_b64_tr_b16 v[70:71], v1 offset:30368
    s_or_b64 vcc, vcc, s[100:101]
    s_cbranch_scc1 Lfb1
Lret1:
    s_add_u32 s29, s29, 1
    s_add_u32 s40, s40, 16384
    s_cmp_ge_u32 s40, 98304
    s_cselect_b32 s40, 0, s40
    s_setprio 3
    s_cmp_eq_u32 s38, 0
    s_cbranch_scc1 Lv0
    s_waitcnt vmcnt(8)
    s_barrier
    s_branch Lv1
Lv0:
    s_cmp_eq_u32 s29, 8
    s_cbranch_scc1 Lv1
    s_waitcnt vmcnt(0)
    s_barrier
Lv1:
    s_waitcnt lgkmcnt(8)
    v_mfma_f32_16x16x32_bf16 v[72:75], v[40:43], v[24:27], v[72:75]
    v_add_f32 v4, v4, v28
    v_add_f32 v5, v5, v36
    v_add_u32 v1, s47, v1
    s_mov_b32 s38, 0
    s_cmp_lt_u32 s29, s34
    s_cbranch_scc1 Lnl2
    s_cmp_ge_u32 s29, s35
    s_cbranch_scc1 Lnl2
    s_mov_b32 m0, s31
    s_add_u32 s36, s31, 32
    buffer_load_dwordx4 v6, s[16:19], s32 offen  lds
    s_mov_b32 m0, s36
    s_add_u32 s36, s31, 8448
    buffer_load_dwordx4 v6, s[16:19], s32 offen offset:1024  lds
    s_mov_b32 m0, s36
    s_add_u32 s36, s31, 8480
    buffer_load_dwordx4 v6, s[20:23], s33 offen  lds
    s_mov_b32 m0, s36
    s_add_u32 s31, s31, 16896
    buffer_load_dwordx4 v6, s[20:23], s33 offen offset:1024  lds
    s_add_u32 s32, s32, 8192
    s_cmp_ge_u32 s32, 98304
    s_cselect_b32 s36, 98304, 0
    s_sub_u32 s32, s32, s36
    s_add_u32 s33, s33, 8192
    s_mov_b32 m0, s31
    s_add_u32 s36, s31, 32
    buffer_load_dwordx4 v6, s[16:19], s32 offen  lds
    s_mov_b32 m0, s36
    s_add_u32 s36, s31, 8448
    buffer_load_dwordx4 v6, s[16:19], s32 offen offset:1024  lds
    s_mov_b32 m0, s36
    s_add_u32 s36, s31, 8480
    buffer_load_dwordx4 v6, s[20:23], s33 offen  lds
    s_mov_b32 m0, s36
    s_add_u32 s31, s31, 16896
    buffer_load_dwordx4 v6, s[20:23], s33 offen offset:1024  lds
    s_add_u32 s32, s32, 8192
    s_cmp_ge_u32 s32, 98304
    s_cselect_b32 s36, 98304, 0
    s_sub_u32 s32, s32, s36
    s_add_u32 s33, s33, 8192
    s_cmp_ge_u32 s33, 98304
    s_cselect_b32 s36, 98304, 0
    s_sub_u32 s33, s33, s36
    s_cmp_ge_u32 s31, 101376
    s_cselect_b32 s36, 101376, 0
    s_sub_u32 s31, s31, s36
    s_cmp_lg_u32 s29, 6
    s_cselect_b32 s38, 1, 0
Lnl2:
    v_fma_f32 v8, v8, s30, -v2
    v_fma_f32 v9, v9, s30, -v2
    v_fma_f32 v10, v10, s30, -v2
    v_mfma_f32_16x16x32_bf16 v[76:79], v[40:43], v[32:35], v[76:79]
    ds_read_b128 v[40:43], v0 offset:0
    v_exp_f32 v8, v8
    v_mfma_f32_16x16x32_bf16 v[80:83], v[44:47], v[24:27], v[80:83]
    v_fma_f32 v11, v11, s30, -v2
    v_exp_f32 v9, v9
    v_mfma_f32_16x16x32_bf16 v[84:87], v[44:47], v[32:35], v[84:87]
    ds_read_b128 v[44:47], v0 offset:256
    v_fma_f32 v12, v12, s30, -v2
    v_mfma_f32_16x16x32_bf16 v[88:91], v[48:51], v[24:27], v[88:91]
    v_exp_f32 v10, v10
    v_fma_f32 v13, v13, s30, -v2
    v_mfma_f32_16x16x32_bf16 v[92:95], v[48:51], v[32:35], v[92:95]
    ds_read_b128 v[48:51], v0 offset:512
    v_exp_f32 v11, v11
    v_mfma_f32_16x16x32_bf16 v[96:99], v[52:55], v[24:27], v[96:99]
    v_add_f32 v7, v8, v9
    v_cvt_pk_bf16_f32 v8, v8, v9
    v_fma_f32 v14, v14, s30, -v2
    v_mfma_f32_16x16x32_bf16 v[100:103], v[52:55], v[32:35], v[100:103]
    ds_read_b128 v[52:55], v0 offset:768
    v_exp_f32 v12, v12
    s_waitcnt lgkmcnt(4)
    v_mfma_f32_16x16x32_bf16 v[104:107], v[56:59], v[24:27], v[104:107]
    v_add_f32 v7, v7, v10
    v_fma_f32 v15, v15, s30, -v2
    v_mfma_f32_16x16x32_bf16 v[108:111], v[56:59], v[32:35], v[108:111]
    ds_read_b128 v[56:59], v0 offset:4224
    v_exp_f32 v13, v13
    v_add_f32 v7, v7, v11
    v_mfma_f32_16x16x32_bf16 v[112:115], v[60:63], v[24:27], v[112:115]
    v_cvt_pk_bf16_f32 v9, v10, v11
    v_fma_f32 v16, v16, s30, -v3
    v_mfma_f32_16x16x32_bf16 v[116:119], v[60:63], v[32:35], v[116:119]
    ds_read_b128 v[60:63], v0 offset:4480
    v_exp_f32 v14, v14
    v_add_f32 v7, v7, v12
    v_mfma_f32_16x16x32_bf16 v[120:123], v[64:67], v[24:27], v[120:123]
    v_fma_f32 v17, v17, s30, -v3
    v_exp_f32 v15, v15
    v_mfma_f32_16x16x32_bf16 v[124:127], v[64:67], v[32:35], v[124:127]
    ds_read_b128 v[64:67], v0 offset:4736
    v_cvt_pk_bf16_f32 v10, v12, v13
    v_mfma_f32_16x16x32_bf16 v[128:131], v[68:71], v[24:27], v[128:131]
    v_add_f32 v12, v7, v13
    v_fma_f32 v18, v18, s30, -v3
    v_mfma_f32_16x16x32_bf16 v[132:135], v[68:71], v[32:35], v[132:135]
    ds_read_b128 v[68:71], v0 offset:4992
    v_exp_f32 v16, v16
    v_add_f32 v12, v12, v14
    s_branch Lloop
Ltail:
    s_setprio 1
    v_fma_f32 v35, v35, s30, -v3
    v_exp_f32 v33, v33
    ds_read_b64_tr_b16 v[40:41], v1 offset:25344
    v_add_f32 v28, v28, v31
    v_cvt_pk_bf16_f32 v27, v30, v31
    ds_read_b64_tr_b16 v[42:43], v1 offset:29568
    v_fma_f32 v36, v36, s30, -v3
    v_exp_f32 v34, v34
    ds_read_b64_tr_b16 v[44:45], v1 offset:25376
    v_fma_f32 v37, v37, s30, -v3
    ds_read_b64_tr_b16 v[46:47], v1 offset:29600
    v_exp_f32 v35, v35
    v_add_f32 v7, v32, v33
    ds_read_b64_tr_b16 v[48:49], v1 offset:25600
    v_cvt_pk_bf16_f32 v32, v32, v33
    v_cmp_nge_f32 s[100:101], s44, v28
    ds_read_b64_tr_b16 v[50:51], v1 offset:29824
    v_fma_f32 v38, v38, s30, -v3
    v_exp_f32 v36, v36
    ds_read_b64_tr_b16 v[52:53], v1 offset:25632
    v_add_f32 v7, v7, v34
    ds_read_b64_tr_b16 v[54:55], v1 offset:29856
    v_fma_f32 v39, v39, s30, -v3
    v_exp_f32 v37, v37
    ds_read_b64_tr_b16 v[56:57], v1 offset:25856
    v_add_f32 v7, v7, v35
    v_cvt_pk_bf16_f32 v33, v34, v35
    ds_read_b64_tr_b16 v[58:59], v1 offset:30080
    v_exp_f32 v38, v38
    ds_read_b64_tr_b16 v[60:61], v1 offset:25888
    v_add_f32 v7, v7, v36
    v_exp_f32 v39, v39
    ds_read_b64_tr_b16 v[62:63], v1 offset:30112
    v_cvt_pk_bf16_f32 v34, v36, v37
    v_add_f32 v36, v7, v37
    ds_read_b64_tr_b16 v[64:65], v1 offset:26112
    v_add_f32 v36, v36, v38
    v_add_f32 v36, v36, v39
    ds_read_b64_tr_b16 v[66:67], v1 offset:30336
    v_cvt_pk_bf16_f32 v35, v38, v39
    v_cmp_nge_f32 vcc, s44, v36
    ds_read_b64_tr_b16 v[68:69], v1 offset:26144
    ds_read_b64_tr_b16 v[70:71], v1 offset:30368
    s_or_b64 vcc, vcc, s[100:101]
    s_cbranch_scc1 Lfb1
Lret2:
    s_setprio 0
    s_waitcnt vmcnt(0)
    s_cmp_eq_u32 s42, 0
    s_cbranch_scc1 Lxb0
    s_barrier
    s_sub_u32 s42, s42, 1
Lxb0:
    s_waitcnt lgkmcnt(8)
    v_mfma_f32_16x16x32_bf16 v[72:75], v[40:43], v[24:27], v[72:75]
    v_add_f32 v4, v4, v28
    v_add_f32 v5, v5, v36
    v_mfma_f32_16x16x32_bf16 v[76:79], v[40:43], v[32:35], v[76:79]
    v_mbcnt_lo_u32_b32 v8, -1, 0
    v_mbcnt_hi_u32_b32 v8, -1, v8
    v_mfma_f32_16x16x32_bf16 v[80:83], v[44:47], v[24:27], v[80:83]
    s_lshl_b32 s36, s28, 12
    s_add_u32 s36, s36, 101376
    v_mfma_f32_16x16x32_bf16 v[84:87], v[44:47], v[32:35], v[84:87]
    v_permlane32_swap_b32 v4, v5
    v_and_b32 v9, 15, v8
    v_mfma_f32_16x16x32_bf16 v[88:91], v[48:51], v[24:27], v[88:91]
    v_lshlrev_b32 v10, 7, v9
    v_add_f32 v4, v4, v5
    v_mfma_f32_16x16x32_bf16 v[92:95], v[48:51], v[32:35], v[92:95]
    v_lshrrev_b32 v9, 5, v8
    v_and_b32 v11, 7, v8
    v_mov_b32 v5, v4
    v_mfma_f32_16x16x32_bf16 v[96:99], v[52:55], v[24:27], v[96:99]
    v_xor_b32 v9, v9, v11
    v_lshl_add_u32 v10, v9, 4, v10
    v_mfma_f32_16x16x32_bf16 v[100:103], v[52:55], v[32:35], v[100:103]
    v_permlane16_swap_b32 v4, v5
    v_bfe_u32 v9, v8, 4, 1
    s_waitcnt lgkmcnt(0)
    v_mfma_f32_16x16x32_bf16 v[104:107], v[56:59], v[24:27], v[104:107]
    v_lshl_add_u32 v10, v9, 3, v10
    v_add_f32 v4, v4, v5
    v_mfma_f32_16x16x32_bf16 v[108:111], v[56:59], v[32:35], v[108:111]
    v_add_u32 v10, s36, v10
    v_lshrrev_b32 v9, 3, v8
    v_mfma_f32_16x16x32_bf16 v[112:115], v[60:63], v[24:27], v[112:115]
    v_rcp_f32 v4, v4
    v_xor_b32 v14, v11, v9
    v_lshlrev_b32 v15, 8, v9
    v_mfma_f32_16x16x32_bf16 v[116:119], v[60:63], v[32:35], v[116:119]
    v_mov_b32 v5, v4
    v_lshl_add_u32 v15, v11, 4, v15
    v_mfma_f32_16x16x32_bf16 v[120:123], v[64:67], v[24:27], v[120:123]
    v_lshlrev_b32 v14, 4, v14
    v_permlane32_swap_b32 v4, v5
    v_mfma_f32_16x16x32_bf16 v[124:127], v[64:67], v[32:35], v[124:127]
    v_lshl_add_u32 v14, v9, 7, v14
    v_add_u32 v14, s36, v14
    v_mfma_f32_16x16x32_bf16 v[128:131], v[68:71], v[24:27], v[128:131]
    v_xor_b32 v11, 32, v10
    v_xor_b32 v12, 64, v10
    v_mfma_f32_16x16x32_bf16 v[132:135], v[68:71], v[32:35], v[132:135]
    v_xor_b32 v13, 96, v10
    s_lshl_b32 s36, s28, 13
    s_add_u32 s38, s36, 4096
    v_mul_f32 v72, v72, v4
    v_mul_f32 v73, v73, v4
    v_mul_f32 v74, v74, v4
    v_mul_f32 v75, v75, v4
    v_cvt_pk_bf16_f32 v72, v72, v73
    v_cvt_pk_bf16_f32 v73, v74, v75
    ds_write_b64 v10, v[72:73] offset:0
    v_mul_f32 v76, v76, v5
    v_mul_f32 v77, v77, v5
    v_mul_f32 v78, v78, v5
    v_mul_f32 v79, v79, v5
    v_cvt_pk_bf16_f32 v76, v76, v77
    v_cvt_pk_bf16_f32 v77, v78, v79
    ds_write_b64 v10, v[76:77] offset:2048
    v_mul_f32 v80, v80, v4
    v_mul_f32 v81, v81, v4
    v_mul_f32 v82, v82, v4
    v_mul_f32 v83, v83, v4
    v_cvt_pk_bf16_f32 v80, v80, v81
    v_cvt_pk_bf16_f32 v81, v82, v83
    ds_write_b64 v11, v[80:81] offset:0
    v_mul_f32 v84, v84, v5
    v_mul_f32 v85, v85, v5
    v_mul_f32 v86, v86, v5
    v_mul_f32 v87, v87, v5
    v_cvt_pk_bf16_f32 v84, v84, v85
    v_cvt_pk_bf16_f32 v85, v86, v87
    ds_write_b64 v11, v[84:85] offset:2048
    v_mul_f32 v88, v88, v4
    v_mul_f32 v89, v89, v4
    v_mul_f32 v90, v90, v4
    v_mul_f32 v91, v91, v4
    v_cvt_pk_bf16_f32 v88, v88, v89
    v_cvt_pk_bf16_f32 v89, v90, v91
    ds_write_b64 v12, v[88:89] offset:0
    v_mul_f32 v92, v92, v5
    v_mul_f32 v93, v93, v5
    v_mul_f32 v94, v94, v5
    v_mul_f32 v95, v95, v5
    v_cvt_pk_bf16_f32 v92, v92, v93
    v_cvt_pk_bf16_f32 v93, v94, v95
    ds_write_b64 v12, v[92:93] offset:2048
    v_mul_f32 v96, v96, v4
    v_mul_f32 v97, v97, v4
    v_mul_f32 v98, v98, v4
    v_mul_f32 v99, v99, v4
    v_cvt_pk_bf16_f32 v96, v96, v97
    v_cvt_pk_bf16_f32 v97, v98, v99
    ds_write_b64 v13, v[96:97] offset:0
    v_mul_f32 v100, v100, v5
    v_mul_f32 v101, v101, v5
    v_mul_f32 v102, v102, v5
    v_mul_f32 v103, v103, v5
    v_cvt_pk_bf16_f32 v100, v100, v101
    v_cvt_pk_bf16_f32 v101, v102, v103
    ds_write_b64 v13, v[100:101] offset:2048
    ds_read_b128 v[40:43], v14 offset:0
    ds_read_b128 v[44:47], v14 offset:1024
    ds_read_b128 v[48:51], v14 offset:2048
    ds_read_b128 v[52:55], v14 offset:3072
    v_mul_f32 v104, v104, v4
    v_mul_f32 v105, v105, v4
    v_mul_f32 v106, v106, v4
    v_mul_f32 v107, v107, v4
    v_cvt_pk_bf16_f32 v104, v104, v105
    v_cvt_pk_bf16_f32 v105, v106, v107
    ds_write_b64 v10, v[104:105] offset:0
    v_mul_f32 v108, v108, v5
    v_mul_f32 v109, v109, v5
    v_mul_f32 v110, v110, v5
    v_mul_f32 v111, v111, v5
    v_cvt_pk_bf16_f32 v108, v108, v109
    v_cvt_pk_bf16_f32 v109, v110, v111
    ds_write_b64 v10, v[108:109] offset:2048
    v_mul_f32 v112, v112, v4
    v_mul_f32 v113, v113, v4
    v_mul_f32 v114, v114, v4
    v_mul_f32 v115, v115, v4
    v_cvt_pk_bf16_f32 v112, v112, v113
    v_cvt_pk_bf16_f32 v113, v114, v115
    ds_write_b64 v11, v[112:113] offset:0
    v_mul_f32 v116, v116, v5
    v_mul_f32 v117, v117, v5
    v_mul_f32 v118, v118, v5
    v_mul_f32 v119, v119, v5
    v_cvt_pk_bf16_f32 v116, v116, v117
    v_cvt_pk_bf16_f32 v117, v118, v119
    ds_write_b64 v11, v[116:117] offset:2048
    s_waitcnt lgkmcnt(7)
    buffer_store_dwordx4 v[40:43], v15, s[24:27], s36 offen offset:0 sc1
    s_waitcnt lgkmcnt(6)
    buffer_store_dwordx4 v[44:47], v15, s[24:27], s36 offen offset:2048 sc1
    s_waitcnt lgkmcnt(5)
    buffer_store_dwordx4 v[48:51], v15, s[24:27], s38 offen offset:0 sc1
    s_waitcnt lgkmcnt(4)
    buffer_store_dwordx4 v[52:55], v15, s[24:27], s38 offen offset:2048 sc1
    s_cmp_eq_u32 s42, 0
    s_cbranch_scc1 Lxb1
    s_barrier
    s_sub_u32 s42, s42, 1
Lxb1:
    v_mul_f32 v120, v120, v4
    v_mul_f32 v121, v121, v4
    v_mul_f32 v122, v122, v4
    v_mul_f32 v123, v123, v4
    v_cvt_pk_bf16_f32 v120, v120, v121
    v_cvt_pk_bf16_f32 v121, v122, v123
    ds_write_b64 v12, v[120:121] offset:0
    v_mul_f32 v124, v124, v5
    v_mul_f32 v125, v125, v5
    v_mul_f32 v126, v126, v5
    v_mul_f32 v127, v127, v5
    v_cvt_pk_bf16_f32 v124, v124, v125
    v_cvt_pk_bf16_f32 v125, v126, v127
    ds_write_b64 v12, v[124:125] offset:2048
    v_mul_f32 v128, v128, v4
    v_mul_f32 v129, v129, v4
    v_mul_f32 v130, v130, v4
    v_mul_f32 v131, v131, v4
    v_cvt_pk_bf16_f32 v128, v128, v129
    v_cvt_pk_bf16_f32 v129, v130, v131
    ds_write_b64 v13, v[128:129] offset:0
    v_mul_f32 v132, v132, v5
    v_mul_f32 v133, v133, v5
    v_mul_f32 v134, v134, v5
    v_mul_f32 v135, v135, v5
    v_cvt_pk_bf16_f32 v132, v132, v133
    v_cvt_pk_bf16_f32 v133, v134, v135
    ds_write_b64 v13, v[132:133] offset:2048
    ds_read_b128 v[56:59], v14 offset:0
    ds_read_b128 v[60:63], v14 offset:1024
    ds_read_b128 v[64:67], v14 offset:2048
    ds_read_b128 v[68:71], v14 offset:3072
    s_waitcnt lgkmcnt(3)
    buffer_store_dwordx4 v[56:59], v15, s[24:27], s36 offen offset:128 sc1
    s_waitcnt lgkmcnt(2)
    buffer_store_dwordx4 v[60:63], v15, s[24:27], s36 offen offset:2176 sc1
    s_waitcnt lgkmcnt(1)
    buffer_store_dwordx4 v[64:67], v15, s[24:27], s38 offen offset:128 sc1
    s_waitcnt lgkmcnt(0)
    buffer_store_dwordx4 v[68:71], v15, s[24:27], s38 offen offset:2176 sc1
Lcatch:
    s_cmp_eq_u32 s42, 0
    s_cbranch_scc1 Lcatch2
    s_barrier
    s_sub_u32 s42, s42, 1
    s_branch Lcatch
Lcatch2:
Lend:
    s_endpgm
Lfb0:
    s_waitcnt lgkmcnt(0)
    v_mbcnt_lo_u32_b32 v40, -1, 0
    v_mbcnt_hi_u32_b32 v40, -1, v40
    v_and_b32 v7, 15, v40
    v_lshlrev_b32 v7, 8, v7
    v_lshrrev_b32 v40, 4, v40
    v_lshl_add_u32 v7, v40, 4, v7
    s_add_u32 s36, s40, 0
    buffer_load_dwordx4 v[40:43], v7, s[16:19], s36 offen offset:0
    buffer_load_dwordx4 v[44:47], v7, s[16:19], s36 offen offset:64
    buffer_load_dwordx4 v[48:51], v7, s[16:19], s36 offen offset:128
    buffer_load_dwordx4 v[52:55], v7, s[16:19], s36 offen offset:192
    s_add_u32 s36, s36, 4096
    buffer_load_dwordx4 v[56:59], v7, s[16:19], s36 offen offset:0
    buffer_load_dwordx4 v[60:63], v7, s[16:19], s36 offen offset:64
    buffer_load_dwordx4 v[64:67], v7, s[16:19], s36 offen offset:128
    buffer_load_dwordx4 v[68:71], v7, s[16:19], s36 offen offset:192
    s_waitcnt vmcnt(0)
    v_mfma_f32_16x16x32_bf16 v[8:11], v[40:43], v[136:139], 0
    v_mfma_f32_16x16x32_bf16 v[16:19], v[40:43], v[152:155], 0
    v_mfma_f32_16x16x32_bf16 v[8:11], v[44:47], v[140:143], v[8:11]
    v_mfma_f32_16x16x32_bf16 v[16:19], v[44:47], v[156:159], v[16:19]
    v_mfma_f32_16x16x32_bf16 v[8:11], v[48:51], v[144:147], v[8:11]
    v_mfma_f32_16x16x32_bf16 v[16:19], v[48:51], v[160:163], v[16:19]
    v_mfma_f32_16x16x32_bf16 v[8:11], v[52:55], v[148:151], v[8:11]
    v_mfma_f32_16x16x32_bf16 v[16:19], v[52:55], v[164:167], v[16:19]
    v_mfma_f32_16x16x32_bf16 v[12:15], v[56:59], v[136:139], 0
    v_mfma_f32_16x16x32_bf16 v[20:23], v[56:59], v[152:155], 0
    v_mfma_f32_16x16x32_bf16 v[12:15], v[60:63], v[140:143], v[12:15]
    v_mfma_f32_16x16x32_bf16 v[20:23], v[60:63], v[156:159], v[20:23]
    v_mfma_f32_16x16x32_bf16 v[12:15], v[64:67], v[144:147], v[12:15]
    v_mfma_f32_16x16x32_bf16 v[20:23], v[64:67], v[160:163], v[20:23]
    v_mfma_f32_16x16x32_bf16 v[12:15], v[68:71], v[148:151], v[12:15]
    v_mfma_f32_16x16x32_bf16 v[20:23], v[68:71], v[164:167], v[20:23]
    s_nop 7
    s_nop 3
    v_max3_f32 v40, v8, v9, v10
    v_max3_f32 v41, v16, v17, v18
    v_max3_f32 v40, v40, v11, v12
    v_max3_f32 v41, v41, v19, v20
    v_max3_f32 v40, v40, v13, v14
    v_max3_f32 v41, v41, v21, v22
    v_max_f32 v40, v40, v15
    v_max_f32 v41, v41, v23
    s_nop 1
    v_permlane32_swap_b32 v40, v41
    v_max_f32 v40, v40, v41
    v_mov_b32 v41, v40
    s_nop 1
    v_permlane16_swap_b32 v40, v41
    v_max_f32 v40, v40, v41
    v_mul_f32 v40, s30, v40
    v_mov_b32 v41, v40
    s_nop 1
    v_permlane32_swap_b32 v40, v41
    v_max_f32 v40, v40, v2
    v_sub_f32 v42, v2, v40
    v_exp_f32 v42, v42
    v_mov_b32 v2, v40
    v_mul_f32 v4, v4, v42
    v_max_f32 v41, v41, v3
    v_sub_f32 v43, v3, v41
    v_exp_f32 v43, v43
    v_mov_b32 v3, v41
    v_mul_f32 v5, v5, v43
    v_mul_f32 v72, v72, v42
    v_mul_f32 v73, v73, v42
    v_mul_f32 v74, v74, v42
    v_mul_f32 v75, v75, v42
    v_mul_f32 v76, v76, v43
    v_mul_f32 v77, v77, v43
    v_mul_f32 v78, v78, v43
    v_mul_f32 v79, v79, v43
    v_mul_f32 v80, v80, v42
    v_mul_f32 v81, v81, v42
    v_mul_f32 v82, v82, v42
    v_mul_f32 v83, v83, v42
    v_mul_f32 v84, v84, v43
    v_mul_f32 v85, v85, v43
    v_mul_f32 v86, v86, v43
    v_mul_f32 v87, v87, v43
    v_mul_f32 v88, v88, v42
    v_mul_f32 v89, v89, v42
    v_mul_f32 v90, v90, v42
    v_mul_f32 v91, v91, v42
    v_mul_f32 v92, v92, v43
    v_mul_f32 v93, v93, v43
    v_mul_f32 v94, v94, v43
    v_mul_f32 v95, v95, v43
    v_mul_f32 v96, v96, v42
    v_mul_f32 v97, v97, v42
    v_mul_f32 v98, v98, v42
    v_mul_f32 v99, v99, v42
    v_mul_f32 v100, v100, v43
    v_mul_f32 v101, v101, v43
    v_mul_f32 v102, v102, v43
    v_mul_f32 v103, v103, v43
    v_mul_f32 v104, v104, v42
    v_mul_f32 v105, v105, v42
    v_mul_f32 v106, v106, v42
    v_mul_f32 v107, v107, v42
    v_mul_f32 v108, v108, v43
    v_mul_f32 v109, v109, v43
    v_mul_f32 v110, v110, v43
    v_mul_f32 v111, v111, v43
    v_mul_f32 v112, v112, v42
    v_mul_f32 v113, v113, v42
    v_mul_f32 v114, v114, v42
    v_mul_f32 v115, v115, v42
    v_mul_f32 v116, v116, v43
    v_mul_f32 v117, v117, v43
    v_mul_f32 v118, v118, v43
    v_mul_f32 v119, v119, v43
    v_mul_f32 v120, v120, v42
    v_mul_f32 v121, v121, v42
    v_mul_f32 v122, v122, v42
    v_mul_f32 v123, v123, v42
    v_mul_f32 v124, v124, v43
    v_mul_f32 v125, v125, v43
    v_mul_f32 v126, v126, v43
    v_mul_f32 v127, v127, v43
    v_mul_f32 v128, v128, v42
    v_mul_f32 v129, v129, v42
    v_mul_f32 v130, v130, v42
    v_mul_f32 v131, v131, v42
    v_mul_f32 v132, v132, v43
    v_mul_f32 v133, v133, v43
    v_mul_f32 v134, v134, v43
    v_mul_f32 v135, v135, v43
    s_nop 1
    ds_read_b64_tr_b16 v[40:41], v1 offset:8448
    ds_read_b64_tr_b16 v[42:43], v1 offset:12672
    ds_read_b64_tr_b16 v[44:45], v1 offset:8480
    ds_read_b64_tr_b16 v[46:47], v1 offset:12704
    ds_read_b64_tr_b16 v[48:49], v1 offset:8704
    ds_read_b64_tr_b16 v[50:51], v1 offset:12928
    ds_read_b64_tr_b16 v[52:53], v1 offset:8736
    ds_read_b64_tr_b16 v[54:55], v1 offset:12960
    ds_read_b64_tr_b16 v[56:57], v1 offset:8960
    ds_read_b64_tr_b16 v[58:59], v1 offset:13184
    ds_read_b64_tr_b16 v[60:61], v1 offset:8992
    ds_read_b64_tr_b16 v[62:63], v1 offset:13216
    ds_read_b64_tr_b16 v[64:65], v1 offset:9216
    ds_read_b64_tr_b16 v[66:67], v1 offset:13440
    ds_read_b64_tr_b16 v[68:69], v1 offset:9248
    ds_read_b64_tr_b16 v[70:71], v1 offset:13472
    v_fma_f32 v8, v8, s30, -v2
    v_fma_f32 v9, v9, s30, -v2
    v_fma_f32 v10, v10, s30, -v2
    v_exp_f32 v8, v8
    v_fma_f32 v11, v11, s30, -v2
    v_exp_f32 v9, v9
    v_fma_f32 v12, v12, s30, -v2
    v_exp_f32 v10, v10
    v_fma_f32 v13, v13, s30, -v2
    v_exp_f32 v11, v11
    v_add_f32 v7, v8, v9
    v_cvt_pk_bf16_f32 v8, v8, v9
    v_fma_f32 v14, v14, s30, -v2
    v_exp_f32 v12, v12
    v_add_f32 v7, v7, v10
    v_fma_f32 v15, v15, s30, -v2
    v_exp_f32 v13, v13
    v_add_f32 v7, v7, v11
    v_cvt_pk_bf16_f32 v9, v10, v11
    v_fma_f32 v16, v16, s30, -v3
    v_exp_f32 v14, v14
    v_add_f32 v7, v7, v12
    v_fma_f32 v17, v17, s30, -v3
    v_exp_f32 v15, v15
    v_cvt_pk_bf16_f32 v10, v12, v13
    v_add_f32 v12, v7, v13
    v_fma_f32 v18, v18, s30, -v3
    v_exp_f32 v16, v16
    v_add_f32 v12, v12, v14
    v_fma_f32 v19, v19, s30, -v3
    v_exp_f32 v17, v17
    v_add_f32 v12, v12, v15
    v_cvt_pk_bf16_f32 v11, v14, v15
    v_fma_f32 v20, v20, s30, -v3
    v_exp_f32 v18, v18
    v_fma_f32 v21, v21, s30, -v3
    v_exp_f32 v19, v19
    v_add_f32 v7, v16, v17
    v_cvt_pk_bf16_f32 v16, v16, v17
    v_fma_f32 v22, v22, s30, -v3
    v_exp_f32 v20, v20
    v_add_f32 v7, v7, v18
    v_fma_f32 v23, v23, s30, -v3
    v_exp_f32 v21, v21
    v_add_f32 v7, v7, v19
    v_cvt_pk_bf16_f32 v17, v18, v19
    v_exp_f32 v22, v22
    v_add_f32 v7, v7, v20
    v_exp_f32 v23, v23
    v_cvt_pk_bf16_f32 v18, v20, v21
    v_add_f32 v20, v7, v21
    v_add_f32 v20, v20, v22
    v_add_f32 v20, v20, v23
    v_cvt_pk_bf16_f32 v19, v22, v23
    s_waitcnt lgkmcnt(0)
    s_branch Lret0
Lfb1:
    s_waitcnt lgkmcnt(0)
    v_mbcnt_lo_u32_b32 v40, -1, 0
    v_mbcnt_hi_u32_b32 v40, -1, v40
    v_and_b32 v7, 15, v40
    v_lshlrev_b32 v7, 8, v7
    v_lshrrev_b32 v40, 4, v40
    v_lshl_add_u32 v7, v40, 4, v7
    s_add_u32 s36, s40, 8192
    buffer_load_dwordx4 v[40:43], v7, s[16:19], s36 offen offset:0
    buffer_load_dwordx4 v[44:47], v7, s[16:19], s36 offen offset:64
    buffer_load_dwordx4 v[48:51], v7, s[16:19], s36 offen offset:128
    buffer_load_dwordx4 v[52:55], v7, s[16:19], s36 offen offset:192
    s_add_u32 s36, s36, 4096
    buffer_load_dwordx4 v[56:59], v7, s[16:19], s36 offen offset:0
    buffer_load_dwordx4 v[60:63], v7, s[16:19], s36 offen offset:64
    buffer_load_dwordx4 v[64:67], v7, s[16:19], s36 offen offset:128
    buffer_load_dwordx4 v[68:71], v7, s[16:19], s36 offen offset:192
    s_waitcnt vmcnt(0)
    v_mfma_f32_16x16x32_bf16 v[24:27], v[40:43], v[136:139], 0
    v_mfma_f32_16x16x32_bf16 v[32:35], v[40:43], v[152:155], 0
    v_mfma_f32_16x16x32_bf16 v[24:27], v[44:47], v[140:143], v[24:27]
    v_mfma_f32_16x16x32_bf16 v[32:35], v[44:47], v[156:159], v[32:35]
    v_mfma_f32_16x16x32_bf16 v[24:27], v[48:51], v[144:147], v[24:27]
    v_mfma_f32_16x16x32_bf16 v[32:35], v[48:51], v[160:163], v[32:35]
    v_mfma_f32_16x16x32_bf16 v[24:27], v[52:55], v[148:151], v[24:27]
    v_mfma_f32_16x16x32_bf16 v[32:35], v[52:55], v[164:167], v[32:35]
    v_mfma_f32_16x16x32_bf16 v[28:31], v[56:59], v[136:139], 0
    v_mfma_f32_16x16x32_bf16 v[36:39], v[56:59], v[152:155], 0
    v_mfma_f32_16x16x32_bf16 v[28:31], v[60:63], v[140:143], v[28:31]
    v_mfma_f32_16x16x32_bf16 v[36:39], v[60:63], v[156:159], v[36:39]
    v_mfma_f32_16x16x32_bf16 v[28:31], v[64:67], v[144:147], v[28:31]
    v_mfma_f32_16x16x32_bf16 v[36:39], v[64:67], v[160:163], v[36:39]
    v_mfma_f32_16x16x32_bf16 v[28:31], v[68:71], v[148:151], v[28:31]
    v_mfma_f32_16x16x32_bf16 v[36:39], v[68:71], v[164:167], v[36:39]
    s_nop 7
    s_nop 3
    v_max3_f32 v40, v24, v25, v26
    v_max3_f32 v41, v32, v33, v34
    v_max3_f32 v40, v40, v27, v28
    v_max3_f32 v41, v41, v35, v36
    v_max3_f32 v40, v40, v29, v30
    v_max3_f32 v41, v41, v37, v38
    v_max_f32 v40, v40, v31
    v_max_f32 v41, v41, v39
    s_nop 1
    v_permlane32_swap_b32 v40, v41
    v_max_f32 v40, v40, v41
    v_mov_b32 v41, v40
    s_nop 1
    v_permlane16_swap_b32 v40, v41
    v_max_f32 v40, v40, v41
    v_mul_f32 v40, s30, v40
    v_mov_b32 v41, v40
    s_nop 1
    v_permlane32_swap_b32 v40, v41
    v_max_f32 v40, v40, v2
    v_sub_f32 v42, v2, v40
    v_exp_f32 v42, v42
    v_mov_b32 v2, v40
    v_mul_f32 v4, v4, v42
    v_max_f32 v41, v41, v3
    v_sub_f32 v43, v3, v41
    v_exp_f32 v43, v43
    v_mov_b32 v3, v41
    v_mul_f32 v5, v5, v43
    v_mul_f32 v72, v72, v42
    v_mul_f32 v73, v73, v42
    v_mul_f32 v74, v74, v42
    v_mul_f32 v75, v75, v42
    v_mul_f32 v76, v76, v43
    v_mul_f32 v77, v77, v43
    v_mul_f32 v78, v78, v43
    v_mul_f32 v79, v79, v43
    v_mul_f32 v80, v80, v42
    v_mul_f32 v81, v81, v42
    v_mul_f32 v82, v82, v42
    v_mul_f32 v83, v83, v42
    v_mul_f32 v84, v84, v43
    v_mul_f32 v85, v85, v43
    v_mul_f32 v86, v86, v43
    v_mul_f32 v87, v87, v43
    v_mul_f32 v88, v88, v42
    v_mul_f32 v89, v89, v42
    v_mul_f32 v90, v90, v42
    v_mul_f32 v91, v91, v42
    v_mul_f32 v92, v92, v43
    v_mul_f32 v93, v93, v43
    v_mul_f32 v94, v94, v43
    v_mul_f32 v95, v95, v43
    v_mul_f32 v96, v96, v42
    v_mul_f32 v97, v97, v42
    v_mul_f32 v98, v98, v42
    v_mul_f32 v99, v99, v42
    v_mul_f32 v100, v100, v43
    v_mul_f32 v101, v101, v43
    v_mul_f32 v102, v102, v43
    v_mul_f32 v103, v103, v43
    v_mul_f32 v104, v104, v42
    v_mul_f32 v105, v105, v42
    v_mul_f32 v106, v106, v42
    v_mul_f32 v107, v107, v42
    v_mul_f32 v108, v108, v43
    v_mul_f32 v109, v109, v43
    v_mul_f32 v110, v110, v43
    v_mul_f32 v111, v111, v43
    v_mul_f32 v112, v112, v42
    v_mul_f32 v113, v113, v42
    v_mul_f32 v114, v114, v42
    v_mul_f32 v115, v115, v42
    v_mul_f32 v116, v116, v43
    v_mul_f32 v117, v117, v43
    v_mul_f32 v118, v118, v43
    v_mul_f32 v119, v119, v43
    v_mul_f32 v120, v120, v42
    v_mul_f32 v121, v121, v42
    v_mul_f32 v122, v122, v42
    v_mul_f32 v123, v123, v42
    v_mul_f32 v124, v124, v43
    v_mul_f32 v125, v125, v43
    v_mul_f32 v126, v126, v43
    v_mul_f32 v127, v127, v43
    v_mul_f32 v128, v128, v42
    v_mul_f32 v129, v129, v42
    v_mul_f32 v130, v130, v42
    v_mul_f32 v131, v131, v42
    v_mul_f32 v132, v132, v43
    v_mul_f32 v133, v133, v43
    v_mul_f32 v134, v134, v43
    v_mul_f32 v135, v135, v43
    s_nop 1
    ds_read_b64_tr_b16 v[40:41], v1 offset:25344
    ds_read_b64_tr_b16 v[42:43], v1 offset:29568
    ds_read_b64_tr_b16 v[44:45], v1 offset:25376
    ds_read_b64_tr_b16 v[46:47], v1 offset:29600
    ds_read_b64_tr_b16 v[48:49], v1 offset:25600
    ds_read_b64_tr_b16 v[50:51], v1 offset:29824
    ds_read_b64_tr_b16 v[52:53], v1 offset:25632
    ds_read_b64_tr_b16 v[54:55], v1 offset:29856
    ds_read_b64_tr_b16 v[56:57], v1 offset:25856
    ds_read_b64_tr_b16 v[58:59], v1 offset:30080
    ds_read_b64_tr_b16 v[60:61], v1 offset:25888
    ds_read_b64_tr_b16 v[62:63], v1 offset:30112
    ds_read_b64_tr_b16 v[64:65], v1 offset:26112
    ds_read_b64_tr_b16 v[66:67], v1 offset:30336
    ds_read_b64_tr_b16 v[68:69], v1 offset:26144
    ds_read_b64_tr_b16 v[70:71], v1 offset:30368
    v_fma_f32 v24, v24, s30, -v2
    v_fma_f32 v25, v25, s30, -v2
    v_fma_f32 v26, v26, s30, -v2
    v_exp_f32 v24, v24
    v_fma_f32 v27, v27, s30, -v2
    v_exp_f32 v25, v25
    v_fma_f32 v28, v28, s30, -v2
    v_exp_f32 v26, v26
    v_fma_f32 v29, v29, s30, -v2
    v_exp_f32 v27, v27
    v_add_f32 v7, v24, v25
    v_cvt_pk_bf16_f32 v24, v24, v25
    v_fma_f32 v30, v30, s30, -v2
    v_exp_f32 v28, v28
    v_add_f32 v7, v7, v26
    v_fma_f32 v31, v31, s30, -v2
    v_exp_f32 v29, v29
    v_add_f32 v7, v7, v27
    v_cvt_pk_bf16_f32 v25, v26, v27
    v_fma_f32 v32, v32, s30, -v3
    v_exp_f32 v30, v30
    v_add_f32 v7, v7, v28
    v_fma_f32 v33, v33, s30, -v3
    v_exp_f32 v31, v31
    v_cvt_pk_bf16_f32 v26, v28, v29
    v_add_f32 v28, v7, v29
    v_fma_f32 v34, v34, s30, -v3
    v_exp_f32 v32, v32
    v_add_f32 v28, v28, v30
    v_fma_f32 v35, v35, s30, -v3
    v_exp_f32 v33, v33
    v_add_f32 v28, v28, v31
    v_cvt_pk_bf16_f32 v27, v30, v31
    v_fma_f32 v36, v36, s30, -v3
    v_exp_f32 v34, v34
    v_fma_f32 v37, v37, s30, -v3
    v_exp_f32 v35, v35
    v_add_f32 v7, v32, v33
    v_cvt_pk_bf16_f32 v32, v32, v33
    v_fma_f32 v38, v38, s30, -v3
    v_exp_f32 v36, v36
    v_add_f32 v7, v7, v34
    v_fma_f32 v39, v39, s30, -v3
    v_exp_f32 v37, v37
    v_add_f32 v7, v7, v35
    v_cvt_pk_bf16_f32 v33, v34, v35
    v_exp_f32 v38, v38
    v_add_f32 v7, v7, v36
    v_exp_f32 v39, v39
    v_cvt_pk_bf16_f32 v34, v36, v37
    v_add_f32 v36, v7, v37
    v_add_f32 v36, v36, v38
    v_add_f32 v36, v36, v39
    v_cvt_pk_bf16_f32 v35, v38, v39
    s_waitcnt lgkmcnt(0)
    s_cmp_eq_u32 s29, s39
    s_cbranch_scc1 Lret2
    s_branch Lret1
.section .rodata,"a"
.p2align 6
.amdhsa_kernel standalone__gqa_softmax__near_ridge_kernel
  .amdhsa_next_free_vgpr 168
  .amdhsa_next_free_sgpr 102
  .amdhsa_accum_offset 168
  .amdhsa_group_segment_fixed_size 0
  .amdhsa_kernarg_size 48
  .amdhsa_user_sgpr_count 2
  .amdhsa_user_sgpr_kernarg_segment_ptr 1
  .amdhsa_system_sgpr_workgroup_id_x 1
.end_amdhsa_kernel
```
